```python
import torch

def _softmax(x, axis=-1):
    return torch.softmax(x, dim=axis)
def _gelu(x):
    return torch.nn.functional.gelu(x, approximate="tanh")
def _silu(x):
    return torch.nn.functional.silu(x)
def _sigmoid(x):
    return torch.sigmoid(x)
def _layernorm(x, axis=-1, eps=1e-5):
    m = x.mean(dim=axis, keepdim=True)
    v = x.var(dim=axis, keepdim=True, unbiased=False)
    return (x - m) / torch.sqrt(v + eps)
def _scatter_add(tgt, idx, src, axis=0):
    return tgt.clone().index_add_(axis, idx, src)
def _segment_sum(src, seg, n):
    out = torch.zeros((n,) + src.shape[1:], dtype=src.dtype)
    return out.index_add_(0, seg, src)
def _pad(x, pw):
    flat = tuple(v for pair in reversed(pw) for v in pair)
    return torch.nn.functional.pad(x, flat)

kernel_name = 'recurrent_scan__sliding_block_cached__dense_activation_silu__decode'

def setup_inputs():

    _w = (lambda a: (lambda t: t.to(torch.bfloat16) if t.is_floating_point() else t)(torch.as_tensor(a)))
    def _A_setup():
        B, Sq, D = 4, 1, 576
        Hq, Hkv, Sk, Dh = 32, 16, 4096, 128
        assert Hq % Hkv == 0, (Hq, Hkv)
        return {
            "x": _w((lambda *s: torch.randn(*s, dtype=torch.bfloat16) * 0.1)(B, Sq, D)),
            "k_cache": _w((lambda *s: torch.randn(*s, dtype=torch.bfloat16) * 0.8)(B, Hkv, Sk, Dh)),
            "v_cache": _w((lambda *s: torch.randn(*s, dtype=torch.bfloat16) * 3.2)(B, Hkv, Sk, Dh)),
            "wq": _w((lambda *s: torch.randn(*s, dtype=torch.bfloat16) * 0.8)(D, Hq * Dh) * (D ** -0.5)),
            "wo": _w((lambda *s: torch.randn(*s, dtype=torch.bfloat16) * 3.2)(Hq * Dh, D) * ((Hq * Dh) ** -0.5)),
        }
    _A_in = _A_setup()

    def _B_setup():
        B, S, D, F = 4, 1, 576, 4608
        return {
            "x": _w((lambda *s: torch.randn(*s, dtype=torch.bfloat16) * 0.1)(B, S, D)),
            "w1": _w((lambda *s: torch.randn(*s, dtype=torch.bfloat16) * 3.2)(D, F) * (D ** -0.5)),
            "w2": _w((lambda *s: torch.randn(*s, dtype=torch.bfloat16) * 3.2)(F, D) * (F ** -0.5)),
        }
    _B_in = _B_setup()

    return {
        "A_x": _A_in["x"],
        "A_k_cache": _A_in["k_cache"],
        "A_v_cache": _A_in["v_cache"],
        "A_wq": _A_in["wq"],
        "A_wo": _A_in["wo"],
        "B_x": _B_in["x"],
        "B_w1": _B_in["w1"],
        "B_w2": _B_in["w2"],
    }

def reference(A_x, A_k_cache, A_v_cache, A_wq, A_wo, B_x, B_w1, B_w2):
    def _A_ref(x, k_cache, v_cache, wq, wo):
        B, Sq, D = x.shape
        Hq, Dh = 32, 128
        Hkv, Sk = k_cache.shape[1], k_cache.shape[2]
        W = min(4096, max(256, Sk // 4))
        rep = Hq // Hkv
        q = (lambda x, *d: x.permute(*d))((x @ wq).reshape(B, Sq, Hq, Dh), 0, 2, 1, 3)
        k = (lambda x, n, axis: torch.repeat_interleave(x, n, dim=axis))(k_cache[:, :, Sk - W:, :], rep, axis=1)
        v = (lambda x, n, axis: torch.repeat_interleave(x, n, dim=axis))(v_cache[:, :, Sk - W:, :], rep, axis=1)
        scores = torch.einsum("bhqd,bhkd->bhqk", q, k) * (Dh ** -0.5)
        p = _softmax(scores, axis=-1)
        o = torch.einsum("bhqk,bhkd->bhqd", p, v)
        return (lambda x, *d: x.permute(*d))(o, 0, 2, 1, 3).reshape(B, Sq, Hq * Dh) @ wo

    def _B_ref(x, w1, w2):
        h = torch.einsum("bsd,df->bsf", x, w1)
        h = _silu(h)
        out = torch.einsum("bsf,fd->bsd", h, w2)
        return out

    x = A_x
    xn = _layernorm(x, axis=-1)
    s = _A_ref(xn, A_k_cache, A_v_cache, A_wq, A_wo)
    g = _silu(_B_ref(xn, B_w1, B_w2))
    return x + s * g
```

```asm
; @launch grid=(256,1,1) block=(576,1,1) lds=158208
.amdgcn_target "amdgcn-amd-amdhsa--gfx950"
.text
.globl recurrent_scan__sliding_block_cached__dense_activation_silu__decode_kernel
.p2align 12
.fill 832, 4, 0xbf800000
.p2align 8
.type recurrent_scan__sliding_block_cached__dense_activation_silu__decode_kernel,@function
recurrent_scan__sliding_block_cached__dense_activation_silu__decode_kernel:
    s_load_dwordx16 s[8:23], s[0:1], 0
    s_load_dwordx2 s[24:25], s[0:1], 64
    s_load_dwordx2 s[26:27], s[0:1], 80
    s_load_dwordx2 s[30:31], s[0:1], 72
    s_cmp_ge_u32 s2, 256
    s_cbranch_scc1 L_end
    v_lshrrev_b32 v2, 6, v0
    v_and_b32 v1, 63, v0
    v_readfirstlane_b32 s3, v2
    s_and_b32 s4, s2, 15
    s_lshr_b32 s5, s2, 4
    s_lshr_b32 s6, s2, 7
    s_bfe_u32 s29, s2, 0x10006
    s_lshl1_add_u32 s7, s4, s29
    s_and_b32 s28, s5, 3
    s_getreg_b32 s40, hwreg(HW_REG_XCC_ID, 0, 4)
    s_bitset1_b32 s40, 7
    v_lshlrev_b32 v13, 4, v1
    s_sub_u32 s3, s3, 1
    s_cbranch_scc0 L_stream
    s_mov_b32 s3, 8
    s_getpc_b64 s[52:53]
L_pc:
    v_lshlrev_b32 v4, 7, v1
    v_min_u32 v4, L_end-L_pc, v4
    global_load_dword v5, v4, s[52:53]
    s_mov_b32 m0, 4928
    v_add_u32 v4, 4096, v13
    s_lshl4_add_u32 s53, s4, s5
    v_mov_b32 v7, s53
    v_mov_b32 v6, s40
    s_and_b32 s53, s53, 0xc0
    s_xor_b32 s53, s53, 64
    s_mov_b64 exec, 1
    s_waitcnt lgkmcnt(0)
    s_load_dword s48, s[26:27], 0
    s_load_dword s42, s[30:31], s53
    global_store_byte v7, v6, s[30:31]
    s_mov_b64 exec, -1
    global_load_lds_dwordx4 v13, s[8:9] offset:0
    global_load_lds_dwordx4 v13, s[8:9] offset:1024
    global_load_lds_dwordx4 v13, s[8:9] offset:2048
    global_load_lds_dwordx4 v13, s[8:9] offset:3072
    s_mov_b32 m0, 9024
    s_mov_b32 exec_hi, 0
    global_load_lds_dwordx4 v4, s[8:9]
    s_mov_b32 exec_hi, -1
    s_branch L_service
L_stream:
    s_and_b32 s50, s2, 7
    s_lshr_b32 s51, s4, 3
    s_lshl1_add_u32 s50, s50, s51
    s_lshl1_add_u32 s50, s50, s29
    s_cmp_lg_u32 s6, 0
    s_cselect_b32 s43, s7, s50
    s_sub_u32 s51, 9, s6
    s_mul_i32 s59, s51, 18432
    s_lshl_b32 s50, s51, 10
    s_mul_i32 s34, s51, 589824
    s_lshl_b32 s51, s51, 5
    s_mov_b32 s35, 0x20000
    s_mul_i32 s51, s51, s43
    s_mul_i32 s52, s28, 48
    s_add_u32 s52, s52, s3
    s_mul_i32 s52, s52, s50
    s_mul_i32 s52, s52, 3
    s_add_u32 s42, s51, s52
    v_mul_u32_u24 v9, 57, v1
    v_lshrrev_b32 v9, 10, v9
    v_mul_u32_u24 v10, 288, v9
    v_sub_u32 v10, v13, v10
    v_mad_u32_u24 v2, v9, s50, v10
    s_mul_i32 s56, s50, 24
    s_mul_i32 s57, s3, 864
    s_add_u32 m0, s57, 9728
    s_cmp_lg_u32 s6, 0
    s_cselect_b32 s55, 0, 0x0030000c
    s_or_b32 exec_hi, s55, 0x000ffff3
    s_cmp_lg_u32 s6, 0
    s_cselect_b32 exec_lo, 0xfffcffff, -1
    s_waitcnt lgkmcnt(0)
    s_cselect_b64 s[32:33], s[14:15], s[20:21]
    s_cselect_b64 s[36:37], s[16:17], s[22:23]
    buffer_load_dwordx4 v2, s[32:35], s42 offen nt lds
    s_add_u32 m0, m0, 6912
    s_add_u32 s42, s42, s56
    buffer_load_dwordx4 v2, s[32:35], s42 offen nt lds
    s_add_u32 m0, m0, 6912
    s_add_u32 s42, s42, s56
    buffer_load_dwordx4 v2, s[32:35], s42 offen nt lds
    s_add_u32 m0, m0, 6912
    s_add_u32 s42, s42, s56
    buffer_load_dwordx4 v2, s[32:35], s42 offen nt lds
    s_add_u32 m0, m0, 6912
    s_add_u32 s42, s42, s56
    buffer_load_dwordx4 v2, s[32:35], s42 offen nt lds
    s_add_u32 m0, m0, 6912
    s_add_u32 s42, s42, s56
    buffer_load_dwordx4 v2, s[32:35], s42 offen nt lds
    s_mov_b64 exec, -1
    s_load_dword s48, s[26:27], 0
    s_lshr_b32 s50, s5, 2
    s_lshl_b32 s50, s50, 24
    s_lshl_b32 s51, s4, 20
    s_add_u32 s50, s50, s51
    s_lshl_b32 s51, s28, 16
    s_add_u32 s50, s50, s51
    s_xor_b32 s51, s5, s4
    s_xor_b32 s51, s51, s3
    s_lshl_b32 s51, s51, 12
    s_add_u32 s50, s50, s51
    s_add_u32 s50, s50, 786432
    v_and_b32 v12, 3, v1
    v_lshrrev_b32 v14, 4, v1
    v_lshlrev_b32 v5, 5, v14
    v_xor_b32 v5, v5, v13
    v_add_u32 v5, s50, v5
    v_bfe_u32 v13, v1, 2, 2
    v_lshl_add_u32 v4, v13, 10, s50
    v_lshl_add_u32 v4, v14, 6, v4
    v_lshl_add_u32 v4, v12, 4, v4
    s_mul_i32 s51, s59, s43
    s_add_u32 s38, s51, s59
    s_mov_b32 s39, 0x20000
    s_mul_i32 s52, s28, 288
    s_add_u32 s51, s51, s52
    s_mul_i32 s52, s3, 3456
    s_add_u32 s58, s51, s52
    v_mul_u32_u24 v3, 1152, v9
    v_add_u32 v3, v3, v10
    v_mov_b32 v11, 0xff
    v_mov_b32 v98, 0
    v_mov_b32 v99, 0
    v_mov_b32 v118, 0
    v_mov_b32 v119, 0
    s_mov_b32 s49, 1048576
    v_lshrrev_b32 v6, 2, v1
    v_mul_u32_u24 v6, 288, v6
    v_lshl_add_u32 v6, v12, 3, v6
    s_lshl_b32 s50, s3, 5
    v_add_u32 v6, s50, v6
    v_mul_u32_u24 v7, 400, v12
    v_lshl_add_u32 v7, v14, 4, v7
    s_lshl_b32 s50, s6, 5
    s_add_u32 s50, s50, s7
    s_mul_i32 s51, s50, 9216
    s_lshl_b32 s52, s3, 10
    s_add_u32 s51, s51, s52
    s_lshl_b32 s52, s28, 8
    s_add_u32 s51, s51, s52
    s_add_u32 s51, s51, 4096
    v_lshlrev_b32 v8, 4, v14
    v_lshl_add_u32 v15, v12, 6, v8
    v_add_u32 v8, s51, v15
    s_mul_i32 s51, s28, 9
    s_add_u32 s51, s51, s3
    s_mul_i32 s51, s51, 16640
    s_lshl_b32 s50, s50, 8
    s_add_u32 s51, s51, s50
    s_add_u32 s51, s51, 888832
    v_add_u32 v15, s51, v15
    s_waitcnt vmcnt(2)
    s_lshl_b32 s50, s4, 4
    s_load_dwordx4 s[60:63], s[30:31], s50
    s_waitcnt vmcnt(0)
    global_load_dwordx4 v[16:19], v4, s[10:11] offset:0 nt
    global_load_dwordx4 v[20:23], v4, s[10:11] offset:256 nt
    global_load_dwordx4 v[24:27], v4, s[10:11] offset:512 nt
    global_load_dwordx4 v[28:31], v4, s[10:11] offset:768 nt
    v_xor_b32 v4, 0x8000, v4
    s_waitcnt lgkmcnt(0)
    s_add_u32 s48, s48, 0x01010101
    s_and_b32 s44, s48, 0xff
    s_bfe_u32 s45, s48, 0x80008
    s_bfe_u32 s46, s48, 0x80010
    s_lshr_b32 s47, s48, 24
    s_mul_i32 s40, s40, 0x01010101
    s_mov_b32 s41, s40
    s_xor_b64 s[60:61], s[60:61], s[40:41]
    s_xor_b64 s[62:63], s[62:63], s[40:41]
    s_or_b64 s[60:61], s[60:61], s[62:63]
    s_or_b32 s60, s60, s61
    s_barrier
    ds_read_b64_tr_b16 v[80:81], v6 offset:9728
    ds_read_b64_tr_b16 v[82:83], v6 offset:14336
    ds_read_b64_tr_b16 v[84:85], v6 offset:18944
    ds_read_b64_tr_b16 v[86:87], v6 offset:23552
    ds_read_b64_tr_b16 v[88:89], v6 offset:28160
    ds_read_b64_tr_b16 v[90:91], v6 offset:32768
    ds_read_b64_tr_b16 v[92:93], v6 offset:37376
    ds_read_b64_tr_b16 v[94:95], v6 offset:41984
    ds_read_b64_tr_b16 v[96:97], v6 offset:46592
    ds_read_b128 v[100:103], v7 offset:0
    ds_read_b128 v[104:107], v7 offset:64
    ds_read_b128 v[108:111], v7 offset:128
    ds_read_b128 v[112:115], v7 offset:192
    ds_read_b64 v[116:117], v7 offset:256
    s_waitcnt lgkmcnt(4)
    v_mfma_f32_16x16x32_bf16 v[120:123], v[80:83], v[100:103], 0
    s_waitcnt lgkmcnt(3)
    v_mfma_f32_16x16x32_bf16 v[120:123], v[84:87], v[104:107], v[120:123]
    s_waitcnt lgkmcnt(2)
    v_mfma_f32_16x16x32_bf16 v[120:123], v[88:91], v[108:111], v[120:123]
    s_waitcnt lgkmcnt(1)
    v_mfma_f32_16x16x32_bf16 v[120:123], v[92:95], v[112:115], v[120:123]
    s_waitcnt lgkmcnt(0)
    v_mfma_f32_16x16x32_bf16 v[120:123], v[96:99], v[116:119], v[120:123]
    s_mov_b32 exec_lo, 0x000f000f
    s_mov_b32 exec_hi, 0x000f000f
    s_cmp_lg_u32 s60, 0
    s_nop 4
    v_bfi_b32 v120, v11, s44, v120
    v_bfi_b32 v121, v11, s45, v121
    v_bfi_b32 v122, v11, s46, v122
    v_bfi_b32 v123, v11, s47, v123
    s_cbranch_scc0 L_near1
    global_store_dwordx4 v8, v[120:123], s[26:27] sc1
    s_branch L_sent2
L_near1:
    global_store_dwordx4 v8, v[120:123], s[26:27]
L_sent2:
    s_mov_b64 exec, -1
    v_add_u32 v6, 51200, v6
    s_barrier
    s_waitcnt vmcnt(3)
    global_load_dwordx4 v[32:35], v4, s[10:11] offset:0 nt
    global_load_dwordx4 v[36:39], v4, s[10:11] offset:256 nt
    global_load_dwordx4 v[40:43], v4, s[10:11] offset:512 nt
    global_load_dwordx4 v[44:47], v4, s[10:11] offset:768 nt
    v_bfe_u32 v10, v1, 2, 1
    v_mul_u32_u24 v9, 272, v10
    v_lshl_add_u32 v9, v14, 6, v9
    v_lshl_add_u32 v9, v12, 4, v9
    v_and_b32 v2, 8, v1
    v_cmp_eq_u32 vcc, 0, v2
    v_mov_b32 v4, 544
    s_nop 0
    v_cndmask_b32 v8, v4, v9, vcc
    v_cndmask_b32 v9, v9, v4, vcc
    s_lshr_b32 s50, s3, 1
    s_lshl_b32 s50, s50, 7
    s_and_b32 s51, s3, 1
    s_lshl3_add_u32 s50, s51, s50
    v_lshl_add_u32 v2, v2, 6, s50
    v_lshl_add_u32 v2, v14, 5, v2
    v_lshl_add_u32 v2, v10, 4, v2
    v_lshlrev_b32 v10, 2, v10
    v_lshrrev_b32 v124, 2, v1
    v_and_b32 v125, 7, v124
    v_xor_b32 v125, s3, v125
    v_lshlrev_b32 v124, 8, v124
    v_lshl_add_u32 v124, v125, 5, v124
    v_lshl_add_u32 v124, v12, 3, v124
    v_add_u32 v124, 92672, v124
    v_and_b32 v126, 1, v1
    v_lshlrev_b32 v125, 5, v14
    v_lshl_add_u32 v125, v126, 4, v125
    s_lshl4_add_u32 s50, s4, s5
    s_mul_i32 s50, s50, 1152
    s_lshl_b32 s51, s3, 6
    s_add_u32 s50, s50, s51
    s_add_u32 s50, s50, 593920
    v_lshl_add_u32 v126, v126, 9, s50
    v_lshl_add_u32 v126, v14, 4, v126
    s_lshl_b32 s53, s3, 12
    s_add_u32 m0, s53, 92672
    v_xor_b32 v4, 0x80, v5
    s_waitcnt vmcnt(2)
    global_load_lds_dwordx4 v5, s[12:13] offset:0 nt
    global_load_lds_dwordx4 v4, s[12:13] offset:1024 nt
    global_load_lds_dwordx4 v5, s[12:13] offset:2048 nt
    global_load_lds_dwordx4 v4, s[12:13] offset:3072 nt
    s_add_u32 m0, m0, 32768
    v_xor_b32 v5, 0x8000, v5
    v_xor_b32 v4, 0x8000, v4
    s_lshr_b32 s50, s3, 1
    s_and_b32 s51, s3, 1
    s_lshl2_add_u32 s53, s4, s50
    s_mul_i32 s53, s53, 4608
    s_add_u32 s53, s53, 593920
    s_lshl4_add_u32 s54, s29, s53
    v_lshl_add_u32 v127, v13, 5, s54
    s_cmp_eq_u32 s6, 0
    s_cbranch_scc1 L_addrA
    s_lshl1_add_u32 s55, s29, s51
    s_lshl_b32 s55, s55, 8
    s_add_u32 s53, s53, s55
    v_mul_u32_u24 v128, 1152, v13
    v_lshl_add_u32 v128, v14, 6, v128
    v_lshl_add_u32 v128, v12, 4, v128
    v_add_u32 v128, s53, v128
    s_mul_i32 s50, s50, 400
    s_lshl_b32 s51, s51, 7
    s_add_u32 s50, s50, s51
    v_lshrrev_b32 v13, 5, v1
    v_lshl_add_u32 v129, v13, 6, s50
    v_lshl_add_u32 v129, v12, 4, v129
    v_and_b32 v13, 1, v14
    v_lshl_add_u32 v129, v13, 3, v129
    s_waitcnt vmcnt(2)
    s_branch L_v1
L_addrA:
    s_mul_i32 s50, s7, 9
    s_add_u32 s50, s50, s3
    s_lshl_b32 s50, s50, 10
    s_add_u32 s50, s50, 4096
    v_lshl_add_u32 v128, v1, 4, s50
    s_lshr_b32 s50, s3, 1
    s_lshl_b32 s50, s50, 6
    s_and_b32 s54, s3, 1
    s_lshl3_add_u32 s50, s54, s50
    v_bfe_u32 v129, v1, 2, 2
    v_mul_u32_u24 v129, 400, v129
    v_lshl_add_u32 v129, v12, 4, v129
    v_lshl_add_u32 v129, v14, 1, v129
    v_add_u32 v129, s50, v129
    s_waitcnt vmcnt(2)
    global_load_dwordx4 v[100:103], v128, s[26:27] sc1
L_v1:
    global_load_lds_dwordx4 v5, s[12:13] offset:0 nt
    global_load_lds_dwordx4 v4, s[12:13] offset:1024 nt
    global_load_lds_dwordx4 v5, s[12:13] offset:2048 nt
    global_load_lds_dwordx4 v4, s[12:13] offset:3072 nt
    s_add_u32 m0, s57, 51200
    s_mov_b32 s54, 0x3db504f3
    s_mov_b32 s51, 0xffff0000
    s_mov_b32 s52, 0x3fb8aa3b
    s_barrier
    ds_read_b128 v[48:51], v8 offset:3200
    ds_read_b128 v[52:55], v9 offset:3200
    s_waitcnt lgkmcnt(1)
    v_mfma_f32_16x16x32_bf16 v[56:59], v[16:19], v[48:51], 0
    v_mfma_f32_16x16x32_bf16 v[60:63], v[20:23], v[48:51], 0
    v_mfma_f32_16x16x32_bf16 v[64:67], v[24:27], v[48:51], 0
    v_mfma_f32_16x16x32_bf16 v[68:71], v[28:31], v[48:51], 0
    s_waitcnt lgkmcnt(0)
    v_mfma_f32_16x16x32_bf16 v[56:59], v[32:35], v[52:55], v[56:59]
    v_mfma_f32_16x16x32_bf16 v[60:63], v[36:39], v[52:55], v[60:63]
    v_mfma_f32_16x16x32_bf16 v[64:67], v[40:43], v[52:55], v[64:67]
    v_mfma_f32_16x16x32_bf16 v[68:71], v[44:47], v[52:55], v[68:71]
    s_nop 4
    v_add_f32_dpp v72, v57, v56 quad_perm:[1,1,1,1] row_mask:0xf bank_mask:0xf
    v_add_f32_dpp v73, v61, v60 quad_perm:[1,1,1,1] row_mask:0xf bank_mask:0xf
    v_add_f32_dpp v74, v65, v64 quad_perm:[1,1,1,1] row_mask:0xf bank_mask:0xf
    v_add_f32_dpp v75, v69, v68 quad_perm:[1,1,1,1] row_mask:0xf bank_mask:0xf
    v_add_f32_dpp v72, v58, v72 quad_perm:[2,2,2,2] row_mask:0xf bank_mask:0xf
    v_add_f32_dpp v73, v62, v73 quad_perm:[2,2,2,2] row_mask:0xf bank_mask:0xf
    v_add_f32_dpp v74, v66, v74 quad_perm:[2,2,2,2] row_mask:0xf bank_mask:0xf
    v_add_f32_dpp v75, v70, v75 quad_perm:[2,2,2,2] row_mask:0xf bank_mask:0xf
    v_add_f32_dpp v72, v59, v72 quad_perm:[3,3,3,3] row_mask:0xf bank_mask:0xf
    v_add_f32_dpp v73, v63, v73 quad_perm:[3,3,3,3] row_mask:0xf bank_mask:0xf
    v_add_f32_dpp v74, v67, v74 quad_perm:[3,3,3,3] row_mask:0xf bank_mask:0xf
    v_add_f32_dpp v75, v71, v75 quad_perm:[3,3,3,3] row_mask:0xf bank_mask:0xf
    v_cvt_pk_bf16_f32 v76, v72, v73
    v_cvt_pk_bf16_f32 v77, v74, v75
    v_lshlrev_b32 v72, 16, v76
    v_and_b32 v73, s51, v76
    v_lshlrev_b32 v74, 16, v77
    v_and_b32 v75, s51, v77
    v_pk_mul_f32 v[72:73], v[72:73], s[54:55] op_sel_hi:[1,0]
    v_pk_mul_f32 v[74:75], v[74:75], s[54:55] op_sel_hi:[1,0]
    v_cvt_pk_bf16_f32 v76, v72, v73
    v_cvt_pk_bf16_f32 v77, v74, v75
    v_lshlrev_b32 v72, 16, v76
    v_and_b32 v73, s51, v76
    v_lshlrev_b32 v74, 16, v77
    v_and_b32 v75, s51, v77
    v_max3_f32 v76, v72, v73, v74
    v_max_f32 v76, v76, v75
    s_mov_b32 exec_lo, 0x11111111
    s_mov_b32 exec_hi, 0x11111111
    ds_max_f32 v10, v76 offset:3776
    s_waitcnt lgkmcnt(0)
    s_barrier
    ds_read_b32 v56, v10 offset:3776
    s_waitcnt lgkmcnt(0)
    v_pk_add_f32 v[72:73], v[72:73], v[56:57] op_sel_hi:[1,0] neg_lo:[0,1] neg_hi:[0,1]
    v_pk_add_f32 v[74:75], v[74:75], v[56:57] op_sel_hi:[1,0] neg_lo:[0,1] neg_hi:[0,1]
    v_pk_mul_f32 v[72:73], v[72:73], s[52:53] op_sel_hi:[1,0]
    v_pk_mul_f32 v[74:75], v[74:75], s[52:53] op_sel_hi:[1,0]
    v_exp_f32 v72, v72
    v_exp_f32 v73, v73
    v_exp_f32 v74, v74
    v_exp_f32 v75, v75
    v_cvt_pk_bf16_f32 v76, v72, v73
    v_cvt_pk_bf16_f32 v77, v74, v75
    ds_write_b64 v2, v[76:77] offset:3904
    s_mov_b64 exec, -1
    s_cmp_eq_u32 s6, 0
    s_waitcnt vmcnt(5) lgkmcnt(0)
    s_cbranch_scc1 L_b2c
    s_waitcnt vmcnt(4)
L_b2c:
    s_barrier
    ds_read_b128 v[16:19], v125 offset:3904
    ds_read_b64_tr_b16 v[48:49], v124 offset:0
    ds_read_b64_tr_b16 v[50:51], v124 offset:4096
    ds_read_b128 v[20:23], v125 offset:4032
    ds_read_b64_tr_b16 v[52:53], v124 offset:8192
    ds_read_b64_tr_b16 v[54:55], v124 offset:12288
    ds_read_b128 v[24:27], v125 offset:4160
    ds_read_b64_tr_b16 v[56:57], v124 offset:16384
    ds_read_b64_tr_b16 v[58:59], v124 offset:20480
    ds_read_b128 v[28:31], v125 offset:4288
    ds_read_b64_tr_b16 v[60:61], v124 offset:24576
    ds_read_b64_tr_b16 v[62:63], v124 offset:28672
    s_waitcnt lgkmcnt(9)
    v_mfma_f32_16x16x32_bf16 v[120:123], v[48:51], v[16:19], 0
    s_waitcnt lgkmcnt(6)
    v_mfma_f32_16x16x32_bf16 v[120:123], v[52:55], v[20:23], v[120:123]
    s_waitcnt lgkmcnt(3)
    v_mfma_f32_16x16x32_bf16 v[120:123], v[56:59], v[24:27], v[120:123]
    s_waitcnt lgkmcnt(0)
    v_mfma_f32_16x16x32_bf16 v[120:123], v[60:63], v[28:31], v[120:123]
    ds_read_b128 v[32:35], v125 offset:4416
    ds_read_b128 v[36:39], v125 offset:4544
    ds_read_b128 v[40:43], v125 offset:4672
    ds_read_b128 v[44:47], v125 offset:4800
    s_barrier
    s_mov_b32 exec_hi, 0x003fffff
    buffer_load_dwordx4 v3, s[36:39], s58 offen nt lds
    s_add_u32 m0, m0, 6912
    s_add_u32 s58, s58, 27648
    buffer_load_dwordx4 v3, s[36:39], s58 offen nt lds
    s_add_u32 m0, m0, 6912
    s_add_u32 s58, s58, 27648
    buffer_load_dwordx4 v3, s[36:39], s58 offen nt lds
    s_add_u32 m0, m0, 6912
    s_add_u32 s58, s58, 27648
    s_mov_b32 exec_hi, -1
    s_waitcnt vmcnt(3) lgkmcnt(0)
    s_barrier
    ds_read_b64_tr_b16 v[64:65], v124 offset:32768
    ds_read_b64_tr_b16 v[66:67], v124 offset:36864
    ds_read_b64_tr_b16 v[68:69], v124 offset:40960
    ds_read_b64_tr_b16 v[70:71], v124 offset:45056
    ds_read_b64_tr_b16 v[72:73], v124 offset:49152
    ds_read_b64_tr_b16 v[74:75], v124 offset:53248
    ds_read_b64_tr_b16 v[76:77], v124 offset:57344
    ds_read_b64_tr_b16 v[78:79], v124 offset:61440
    s_waitcnt lgkmcnt(6)
    v_mfma_f32_16x16x32_bf16 v[120:123], v[64:67], v[32:35], v[120:123]
    s_waitcnt lgkmcnt(4)
    v_mfma_f32_16x16x32_bf16 v[120:123], v[68:71], v[36:39], v[120:123]
    s_waitcnt lgkmcnt(2)
    v_mfma_f32_16x16x32_bf16 v[120:123], v[72:75], v[40:43], v[120:123]
    s_waitcnt lgkmcnt(0)
    v_mfma_f32_16x16x32_bf16 v[120:123], v[76:79], v[44:47], v[120:123]
    s_mov_b32 exec_lo, 0x00030003
    s_mov_b32 exec_hi, 0x00030003
    s_cmp_lg_u32 s60, 0
    s_nop 4
    v_bfi_b32 v120, v11, s44, v120
    v_bfi_b32 v121, v11, s45, v121
    v_bfi_b32 v122, v11, s46, v122
    v_bfi_b32 v123, v11, s47, v123
    s_cbranch_scc0 L_near3
    global_store_dwordx4 v126, v[120:123], s[26:27] sc1
    s_branch L_sent4
L_near3:
    global_store_dwordx4 v126, v[120:123], s[26:27]
L_sent4:
    s_mov_b64 exec, -1
    s_cmp_eq_u32 s6, 0
    s_cbranch_scc1 L_tailA
    global_load_dwordx4 v[24:27], v127, s[26:27] offset:1024 sc1
    s_barrier
    s_mov_b32 exec_hi, 0x003fffff
    buffer_load_dwordx4 v3, s[36:39], s58 offen nt lds
    s_add_u32 m0, m0, 6912
    s_add_u32 s58, s58, 27648
    buffer_load_dwordx4 v3, s[36:39], s58 offen nt lds
    s_add_u32 m0, m0, 6912
    s_add_u32 s58, s58, 27648
    buffer_load_dwordx4 v3, s[36:39], s58 offen nt lds
    s_add_u32 m0, m0, 6912
    s_add_u32 s58, s58, 27648
    s_mov_b32 exec_hi, -1
    s_waitcnt vmcnt(3)
    global_load_dwordx4 v[20:23], v128, s[26:27] sc1
L_b3c:
    s_barrier
    ds_read_b64_tr_b16 v[80:81], v6 offset:0
    ds_read_b64_tr_b16 v[82:83], v6 offset:4608
    ds_read_b64_tr_b16 v[84:85], v6 offset:9216
    ds_read_b64_tr_b16 v[86:87], v6 offset:13824
    s_cmp_eq_u32 s3, 8
    s_cbranch_scc1 L_b4
    s_branch L_mchk
L_mpoll:
    global_load_dwordx4 v[24:27], v127, s[26:27] offset:1024 sc1
    s_waitcnt vmcnt(0)
L_mchk:
    v_xor_b32 v24, s44, v24
    v_xor_b32 v25, s45, v25
    v_xor_b32 v26, s46, v26
    v_xor_b32 v27, s47, v27
    v_or3_b32 v28, v24, v25, v26
    v_or_b32 v28, v28, v27
    v_and_b32 v28, v11, v28
    v_cmp_ne_u32 vcc, 0, v28
    s_cbranch_vccz L_mgot
    s_sub_u32 s49, s49, 1
    s_cbranch_scc0 L_mpoll
    s_mov_b32 s49, 0
L_mgot:
    v_max_f32_dpp v28, v24, v24 row_ror:4 row_mask:0xf bank_mask:0xf
    s_nop 1
    v_max_f32_dpp v28, v28, v28 row_ror:8 row_mask:0xf bank_mask:0xf
    v_sub_f32 v28, v24, v28
    v_mul_f32 v28, s52, v28
    v_exp_f32 v28, v28
    s_nop 0
    v_mul_f32 v25, v25, v28
    s_nop 1
    v_add_f32_dpp v25, v25, v25 row_ror:8 row_mask:0xf bank_mask:0xf
    s_nop 1
    v_add_f32_dpp v25, v25, v25 row_ror:4 row_mask:0xf bank_mask:0xf
    v_rcp_f32 v25, v25
    s_nop 0
    v_mul_f32 v28, v28, v25
    v_mov_b32 v29, v28
    s_branch L_ochk
L_opoll:
    global_load_dwordx4 v[20:23], v128, s[26:27] sc1
L_ochk:
    s_waitcnt vmcnt(0)
    v_xor_b32 v20, s44, v20
    v_xor_b32 v21, s45, v21
    v_xor_b32 v22, s46, v22
    v_xor_b32 v23, s47, v23
    v_or3_b32 v30, v20, v21, v22
    v_or_b32 v30, v30, v23
    v_and_b32 v30, v11, v30
    v_cmp_ne_u32 vcc, 0, v30
    s_cbranch_vccz L_ogot
    s_sub_u32 s49, s49, 1
    s_cbranch_scc0 L_opoll
    s_mov_b32 s49, 0
L_ogot:
    v_pk_mul_f32 v[20:21], v[20:21], v[28:29]
    v_pk_mul_f32 v[22:23], v[22:23], v[28:29]
    s_nop 0
    v_add_f32_dpp v20, v20, v20 row_ror:8 row_mask:0xf bank_mask:0xf
    v_add_f32_dpp v21, v21, v21 row_ror:8 row_mask:0xf bank_mask:0xf
    v_add_f32_dpp v22, v22, v22 row_ror:8 row_mask:0xf bank_mask:0xf
    v_add_f32_dpp v23, v23, v23 row_ror:8 row_mask:0xf bank_mask:0xf
    v_add_f32_dpp v20, v20, v20 row_ror:4 row_mask:0xf bank_mask:0xf
    v_add_f32_dpp v21, v21, v21 row_ror:4 row_mask:0xf bank_mask:0xf
    v_add_f32_dpp v22, v22, v22 row_ror:4 row_mask:0xf bank_mask:0xf
    v_add_f32_dpp v23, v23, v23 row_ror:4 row_mask:0xf bank_mask:0xf
    v_cvt_pk_bf16_f32 v20, v20, v21
    v_cvt_pk_bf16_f32 v21, v22, v23
    ds_write_b64 v129, v[20:21] offset:1600
    s_waitcnt lgkmcnt(0)
L_b4:
    s_barrier
    ds_read_b128 v[100:103], v7 offset:1600
    ds_read_b128 v[104:107], v7 offset:1664
    ds_read_b128 v[108:111], v7 offset:1728
    ds_read_b64_tr_b16 v[88:89], v6 offset:18432
    ds_read_b64_tr_b16 v[90:91], v6 offset:23040
    ds_read_b128 v[112:115], v7 offset:1792
    ds_read_b64_tr_b16 v[92:93], v6 offset:27648
    ds_read_b64_tr_b16 v[94:95], v6 offset:32256
    s_waitcnt lgkmcnt(7)
    v_mfma_f32_16x16x32_bf16 v[120:123], v[80:83], v[100:103], 0
    s_waitcnt lgkmcnt(6)
    v_mfma_f32_16x16x32_bf16 v[120:123], v[84:87], v[104:107], v[120:123]
    s_waitcnt lgkmcnt(3)
    v_mfma_f32_16x16x32_bf16 v[120:123], v[88:91], v[108:111], v[120:123]
    s_waitcnt lgkmcnt(0)
    v_mfma_f32_16x16x32_bf16 v[120:123], v[92:95], v[112:115], v[120:123]
L_pub:
    s_mov_b32 exec_lo, 0x000f000f
    s_mov_b32 exec_hi, 0x000f000f
    s_nop 5
    v_bfi_b32 v120, v11, s44, v120
    v_bfi_b32 v121, v11, s45, v121
    v_bfi_b32 v122, v11, s46, v122
    v_bfi_b32 v123, v11, s47, v123
    global_store_dwordx4 v15, v[120:123], s[26:27] sc1
    s_mov_b64 exec, -1
    s_cmp_eq_u32 s3, 8
    s_cbranch_scc1 L_final
    s_endpgm
L_tailA:
    s_barrier
    s_mov_b32 exec_hi, 0x003fffff
    buffer_load_dwordx4 v3, s[36:39], s58 offen nt lds
    s_add_u32 m0, m0, 6912
    s_add_u32 s58, s58, 27648
    buffer_load_dwordx4 v3, s[36:39], s58 offen nt lds
    s_add_u32 m0, m0, 6912
    s_add_u32 s58, s58, 27648
    buffer_load_dwordx4 v3, s[36:39], s58 offen nt lds
    s_add_u32 m0, m0, 6912
    s_add_u32 s58, s58, 27648
    s_mov_b32 exec_hi, -1
    s_branch L_hchk
L_hpoll:
    global_load_dwordx4 v[100:103], v128, s[26:27] sc1
    s_waitcnt vmcnt(0)
L_hchk:
    v_xor_b32 v100, s44, v100
    v_xor_b32 v101, s45, v101
    v_xor_b32 v102, s46, v102
    v_xor_b32 v103, s47, v103
    v_or3_b32 v104, v100, v101, v102
    v_or_b32 v104, v104, v103
    v_and_b32 v104, v11, v104
    v_cmp_ne_u32 vcc, 0, v104
    s_cbranch_vccz L_hgot
    s_sub_u32 s49, s49, 1
    s_cbranch_scc0 L_hpoll
    s_mov_b32 s49, 0
L_hgot:
    v_permlane32_swap_b32 v100, v102
    v_permlane32_swap_b32 v101, v103
    v_pk_add_f32 v[100:101], v[100:101], v[102:103]
    s_nop 1
    v_permlane16_swap_b32 v100, v101
    v_add_f32 v100, v100, v101
    v_cvt_pk_bf16_f32 v100, v100, v100
    v_and_b32 v100, 0xffff0000, v100
    v_mul_f32 v101, 0xbfb8aa3b, v100
    v_exp_f32 v101, v101
    s_nop 0
    v_add_f32 v101, 1.0, v101
    v_rcp_f32 v101, v101
    s_nop 0
    v_mul_f32 v100, v100, v101
    v_cvt_pk_bf16_f32 v100, v100, v100
    ds_write_b16 v129, v100 offset:1600
    s_waitcnt vmcnt(3) lgkmcnt(0)
    s_barrier
    ds_read_b128 v[100:103], v7 offset:1600
    ds_read_b128 v[104:107], v7 offset:1664
    ds_read_b128 v[108:111], v7 offset:1728
    ds_read_b128 v[112:115], v7 offset:1792
    ds_read_b64 v[116:117], v7 offset:1856
    ds_read_b64_tr_b16 v[80:81], v6 offset:0
    ds_read_b64_tr_b16 v[82:83], v6 offset:4608
    ds_read_b64_tr_b16 v[84:85], v6 offset:9216
    ds_read_b64_tr_b16 v[86:87], v6 offset:13824
    s_waitcnt lgkmcnt(0)
    v_mfma_f32_16x16x32_bf16 v[120:123], v[80:83], v[100:103], 0
    v_mfma_f32_16x16x32_bf16 v[120:123], v[84:87], v[104:107], v[120:123]
    s_waitcnt vmcnt(0)
    s_barrier
    ds_read_b64_tr_b16 v[88:89], v6 offset:18432
    ds_read_b64_tr_b16 v[90:91], v6 offset:23040
    ds_read_b64_tr_b16 v[92:93], v6 offset:27648
    ds_read_b64_tr_b16 v[94:95], v6 offset:32256
    ds_read_b64_tr_b16 v[96:97], v6 offset:36864
    s_waitcnt lgkmcnt(3)
    v_mfma_f32_16x16x32_bf16 v[120:123], v[88:91], v[108:111], v[120:123]
    s_waitcnt lgkmcnt(1)
    v_mfma_f32_16x16x32_bf16 v[120:123], v[92:95], v[112:115], v[120:123]
    s_waitcnt lgkmcnt(0)
    v_mfma_f32_16x16x32_bf16 v[120:123], v[96:99], v[116:119], v[120:123]
    s_branch L_pub
L_service:
    v_lshrrev_b32 v14, 4, v1
    v_and_b32 v12, 3, v1
    v_and_b32 v13, 15, v1
    v_mul_u32_u24 v2, 1152, v14
    v_lshl_add_u32 v2, v13, 3, v2
    s_mul_i32 s50, s28, 288
    v_add_u32 v16, s50, v2
    s_xor_b32 s50, s2, 0xe0
    s_and_b32 s56, s50, 7
    s_lshr_b32 s51, s50, 5
    s_lshl3_add_u32 s56, s51, s56
    s_bfe_u32 s57, s50, 0x20003
    s_mul_i32 s51, s57, 1152
    s_lshl_b32 s52, s56, 5
    s_add_u32 s51, s51, s52
    v_lshl_add_u32 v3, v12, 3, s51
    v_lshl_add_u32 v3, v14, 1, v3
    v_mov_b32 v11, 0xff
    v_mov_b32 v98, 0
    v_mov_b32 v99, 0
    v_mov_b32 v118, 0
    v_mov_b32 v119, 0
    s_mov_b32 s49, 1048576
    v_lshrrev_b32 v6, 2, v1
    v_mul_u32_u24 v6, 288, v6
    v_lshl_add_u32 v6, v12, 3, v6
    s_lshl_b32 s50, s3, 5
    v_add_u32 v6, s50, v6
    v_mul_u32_u24 v7, 400, v12
    v_lshl_add_u32 v7, v14, 4, v7
    s_lshl_b32 s50, s6, 5
    s_add_u32 s50, s50, s7
    s_mul_i32 s51, s50, 9216
    s_lshl_b32 s52, s3, 10
    s_add_u32 s51, s51, s52
    s_lshl_b32 s52, s28, 8
    s_add_u32 s51, s51, s52
    s_add_u32 s51, s51, 4096
    v_lshlrev_b32 v8, 4, v14
    v_lshl_add_u32 v15, v12, 6, v8
    v_add_u32 v8, s51, v15
    s_mul_i32 s51, s28, 9
    s_add_u32 s51, s51, s3
    s_mul_i32 s51, s51, 16640
    s_lshl_b32 s50, s50, 8
    s_add_u32 s51, s51, s50
    s_add_u32 s51, s51, 888832
    v_add_u32 v15, s51, v15
    ds_write_b64 v98, v[98:99] offset:3744
    ds_write_b64 v98, v[98:99] offset:3752
    v_mov_b32 v20, 0xff800000
    v_mov_b32 v21, v20
    ds_write_b64 v98, v[20:21] offset:3776
    s_mov_b32 s51, 0xffff0000
    v_mul_u32_u24 v9, 400, v14
    v_bfe_u32 v10, v1, 3, 1
    v_lshl_add_u32 v9, v10, 6, v9
    v_lshl_add_u32 v9, v12, 4, v9
    v_bfe_u32 v10, v1, 2, 1
    v_lshl_add_u32 v9, v10, 3, v9
    s_waitcnt vmcnt(0)
    ds_read_b64 v[34:35], v16 offset:4928
    ds_read_b64 v[36:37], v16 offset:5056
    ds_read_b64 v[38:39], v16 offset:5184
    ds_read_b64 v[16:17], v2 offset:4928
    ds_read_b64 v[18:19], v2 offset:5056
    ds_read_b64 v[20:21], v2 offset:5184
    ds_read_b64 v[22:23], v2 offset:5312
    ds_read_b64 v[24:25], v2 offset:5440
    ds_read_b64 v[26:27], v2 offset:5568
    ds_read_b64 v[28:29], v2 offset:5696
    ds_read_b64 v[30:31], v2 offset:5824
    ds_read_b64 v[32:33], v2 offset:5952
    ds_read_u16 v4, v3 offset:4928
    s_waitcnt lgkmcnt(0)
    v_lshlrev_b32 v40, 16, v16
    v_and_b32 v41, s51, v16
    v_lshlrev_b32 v42, 16, v17
    v_and_b32 v43, s51, v17
    v_lshlrev_b32 v44, 16, v18
    v_and_b32 v45, s51, v18
    v_lshlrev_b32 v46, 16, v19
    v_and_b32 v47, s51, v19
    v_lshlrev_b32 v48, 16, v20
    v_and_b32 v49, s51, v20
    v_lshlrev_b32 v50, 16, v21
    v_and_b32 v51, s51, v21
    v_lshlrev_b32 v52, 16, v22
    v_and_b32 v53, s51, v22
    v_lshlrev_b32 v54, 16, v23
    v_and_b32 v55, s51, v23
    v_lshlrev_b32 v56, 16, v24
    v_and_b32 v57, s51, v24
    v_lshlrev_b32 v58, 16, v25
    v_and_b32 v59, s51, v25
    v_lshlrev_b32 v60, 16, v26
    v_and_b32 v61, s51, v26
    v_lshlrev_b32 v62, 16, v27
    v_and_b32 v63, s51, v27
    v_lshlrev_b32 v64, 16, v28
    v_and_b32 v65, s51, v28
    v_lshlrev_b32 v66, 16, v29
    v_and_b32 v67, s51, v29
    v_lshlrev_b32 v68, 16, v30
    v_and_b32 v69, s51, v30
    v_lshlrev_b32 v70, 16, v31
    v_and_b32 v71, s51, v31
    v_lshlrev_b32 v72, 16, v32
    v_and_b32 v73, s51, v32
    v_lshlrev_b32 v74, 16, v33
    v_and_b32 v75, s51, v33
    v_pk_add_f32 v[76:77], v[40:41], v[42:43]
    v_pk_add_f32 v[78:79], v[44:45], v[46:47]
    v_pk_add_f32 v[76:77], v[76:77], v[48:49]
    v_pk_add_f32 v[78:79], v[78:79], v[50:51]
    v_pk_add_f32 v[76:77], v[76:77], v[52:53]
    v_pk_add_f32 v[78:79], v[78:79], v[54:55]
    v_pk_add_f32 v[76:77], v[76:77], v[56:57]
    v_pk_add_f32 v[78:79], v[78:79], v[58:59]
    v_pk_add_f32 v[76:77], v[76:77], v[60:61]
    v_pk_add_f32 v[78:79], v[78:79], v[62:63]
    v_pk_add_f32 v[76:77], v[76:77], v[64:65]
    v_pk_add_f32 v[78:79], v[78:79], v[66:67]
    v_pk_add_f32 v[76:77], v[76:77], v[68:69]
    v_pk_add_f32 v[78:79], v[78:79], v[70:71]
    v_pk_add_f32 v[76:77], v[76:77], v[72:73]
    v_pk_add_f32 v[78:79], v[78:79], v[74:75]
    v_pk_add_f32 v[76:77], v[76:77], v[78:79]
    v_add_f32 v76, v76, v77
    s_nop 1
    v_add_f32_dpp v76, v76, v76 row_ror:8 row_mask:0xf bank_mask:0xf
    s_nop 1
    v_add_f32_dpp v76, v76, v76 row_ror:4 row_mask:0xf bank_mask:0xf
    s_nop 1
    v_add_f32_dpp v76, v76, v76 row_ror:2 row_mask:0xf bank_mask:0xf
    s_nop 1
    v_add_f32_dpp v76, v76, v76 row_ror:1 row_mask:0xf bank_mask:0xf
    v_mul_f32 v16, 0xbae38e39, v76
    v_mov_b32 v17, v16
    v_pk_add_f32 v[40:41], v[40:41], v[16:17]
    v_pk_add_f32 v[42:43], v[42:43], v[16:17]
    v_pk_add_f32 v[44:45], v[44:45], v[16:17]
    v_pk_add_f32 v[46:47], v[46:47], v[16:17]
    v_pk_add_f32 v[48:49], v[48:49], v[16:17]
    v_pk_add_f32 v[50:51], v[50:51], v[16:17]
    v_pk_add_f32 v[52:53], v[52:53], v[16:17]
    v_pk_add_f32 v[54:55], v[54:55], v[16:17]
    v_pk_add_f32 v[56:57], v[56:57], v[16:17]
    v_pk_add_f32 v[58:59], v[58:59], v[16:17]
    v_pk_add_f32 v[60:61], v[60:61], v[16:17]
    v_pk_add_f32 v[62:63], v[62:63], v[16:17]
    v_pk_add_f32 v[64:65], v[64:65], v[16:17]
    v_pk_add_f32 v[66:67], v[66:67], v[16:17]
    v_pk_add_f32 v[68:69], v[68:69], v[16:17]
    v_pk_add_f32 v[70:71], v[70:71], v[16:17]
    v_pk_add_f32 v[72:73], v[72:73], v[16:17]
    v_pk_add_f32 v[74:75], v[74:75], v[16:17]
    v_pk_mul_f32 v[76:77], v[40:41], v[40:41]
    v_pk_mul_f32 v[78:79], v[42:43], v[42:43]
    v_pk_fma_f32 v[76:77], v[44:45], v[44:45], v[76:77]
    v_pk_fma_f32 v[78:79], v[46:47], v[46:47], v[78:79]
    v_pk_fma_f32 v[76:77], v[48:49], v[48:49], v[76:77]
    v_pk_fma_f32 v[78:79], v[50:51], v[50:51], v[78:79]
    v_pk_fma_f32 v[76:77], v[52:53], v[52:53], v[76:77]
    v_pk_fma_f32 v[78:79], v[54:55], v[54:55], v[78:79]
    v_pk_fma_f32 v[76:77], v[56:57], v[56:57], v[76:77]
    v_pk_fma_f32 v[78:79], v[58:59], v[58:59], v[78:79]
    v_pk_fma_f32 v[76:77], v[60:61], v[60:61], v[76:77]
    v_pk_fma_f32 v[78:79], v[62:63], v[62:63], v[78:79]
    v_pk_fma_f32 v[76:77], v[64:65], v[64:65], v[76:77]
    v_pk_fma_f32 v[78:79], v[66:67], v[66:67], v[78:79]
    v_pk_fma_f32 v[76:77], v[68:69], v[68:69], v[76:77]
    v_pk_fma_f32 v[78:79], v[70:71], v[70:71], v[78:79]
    v_pk_fma_f32 v[76:77], v[72:73], v[72:73], v[76:77]
    v_pk_fma_f32 v[78:79], v[74:75], v[74:75], v[78:79]
    v_pk_add_f32 v[76:77], v[76:77], v[78:79]
    v_add_f32 v76, v76, v77
    s_nop 1
    v_add_f32_dpp v76, v76, v76 row_ror:8 row_mask:0xf bank_mask:0xf
    s_nop 1
    v_add_f32_dpp v76, v76, v76 row_ror:4 row_mask:0xf bank_mask:0xf
    s_nop 1
    v_add_f32_dpp v76, v76, v76 row_ror:2 row_mask:0xf bank_mask:0xf
    s_nop 1
    v_add_f32_dpp v76, v76, v76 row_ror:1 row_mask:0xf bank_mask:0xf
    v_mul_f32 v18, 0x3ae38e39, v76
    v_cvt_pk_bf16_f32 v18, v16, v18
    v_lshlrev_b32 v16, 16, v18
    v_and_b32 v18, s51, v18
    v_add_f32 v18, 0x3727c5ac, v18
    v_cvt_pk_bf16_f32 v18, v18, v18
    v_and_b32 v18, s51, v18
    v_sqrt_f32 v18, v18
    v_mov_b32 v17, v16
    v_cvt_pk_bf16_f32 v18, v18, v18
    v_and_b32 v18, s51, v18
    v_rcp_f32 v18, v18
    s_nop 0
    v_mov_b32 v19, v18
    v_lshlrev_b32 v40, 16, v34
    v_and_b32 v41, s51, v34
    v_lshlrev_b32 v42, 16, v35
    v_and_b32 v43, s51, v35
    v_lshlrev_b32 v44, 16, v36
    v_and_b32 v45, s51, v36
    v_lshlrev_b32 v46, 16, v37
    v_and_b32 v47, s51, v37
    v_lshlrev_b32 v48, 16, v38
    v_and_b32 v49, s51, v38
    v_lshlrev_b32 v50, 16, v39
    v_and_b32 v51, s51, v39
    v_pk_add_f32 v[40:41], v[40:41], v[16:17]
    v_pk_add_f32 v[42:43], v[42:43], v[16:17]
    v_pk_add_f32 v[44:45], v[44:45], v[16:17]
    v_pk_add_f32 v[46:47], v[46:47], v[16:17]
    v_pk_add_f32 v[48:49], v[48:49], v[16:17]
    v_pk_add_f32 v[50:51], v[50:51], v[16:17]
    v_cvt_pk_bf16_f32 v34, v40, v41
    v_cvt_pk_bf16_f32 v35, v42, v43
    v_cvt_pk_bf16_f32 v36, v44, v45
    v_cvt_pk_bf16_f32 v37, v46, v47
    v_cvt_pk_bf16_f32 v38, v48, v49
    v_cvt_pk_bf16_f32 v39, v50, v51
    v_lshlrev_b32 v40, 16, v34
    v_and_b32 v41, s51, v34
    v_lshlrev_b32 v42, 16, v35
    v_and_b32 v43, s51, v35
    v_lshlrev_b32 v44, 16, v36
    v_and_b32 v45, s51, v36
    v_lshlrev_b32 v46, 16, v37
    v_and_b32 v47, s51, v37
    v_lshlrev_b32 v48, 16, v38
    v_and_b32 v49, s51, v38
    v_lshlrev_b32 v50, 16, v39
    v_and_b32 v51, s51, v39
    v_pk_mul_f32 v[40:41], v[40:41], v[18:19]
    v_pk_mul_f32 v[42:43], v[42:43], v[18:19]
    v_pk_mul_f32 v[44:45], v[44:45], v[18:19]
    v_pk_mul_f32 v[46:47], v[46:47], v[18:19]
    v_pk_mul_f32 v[48:49], v[48:49], v[18:19]
    v_pk_mul_f32 v[50:51], v[50:51], v[18:19]
    v_cvt_pk_bf16_f32 v34, v40, v41
    v_cvt_pk_bf16_f32 v35, v42, v43
    v_cvt_pk_bf16_f32 v36, v44, v45
    v_cvt_pk_bf16_f32 v37, v46, v47
    v_cvt_pk_bf16_f32 v38, v48, v49
    v_cvt_pk_bf16_f32 v39, v50, v51
    ds_write_b64 v9, v[34:35] offset:0
    ds_write_b64 v9, v[36:37] offset:128
    ds_write_b64 v9, v[38:39] offset:256
    s_mul_i32 s50, s4, 18432
    s_lshr_b32 s52, s5, 2
    s_lshl_b32 s52, s52, 6
    s_add_u32 s50, s50, s52
    s_add_u32 s50, s50, 299008
    v_bfe_u32 v10, v1, 2, 2
    v_lshl_add_u32 v16, v10, 10, s50
    v_lshl_add_u32 v16, v14, 8, v16
    v_lshl_add_u32 v16, v12, 4, v16
    v_add_u32 v17, 4096, v16
    v_add_u32 v18, 9216, v16
    v_add_u32 v19, 13312, v16
    v_lshlrev_b32 v9, 3, v13
    v_lshl_add_u32 v9, v14, 1, v9
    s_lshl4_add_u32 s50, s4, s5
    s_mul_i32 s53, s50, 1152
    s_add_u32 s53, s53, 593920
    s_sub_u32 s50, s53, 10368
    v_mov_b32 v20, s50
    v_mov_b32 v21, s53
    v_cmp_gt_u32 vcc, 9, v1
    s_nop 1
    v_cndmask_b32 v5, v20, v21, vcc
    v_lshl_add_u32 v5, v1, 7, v5
    s_mul_i32 s50, s7, 9216
    s_lshl_b32 s52, s28, 8
    s_add_u32 s50, s50, s52
    s_add_u32 s50, s50, -5120
    v_min_u32 v20, 35, v1
    v_lshrrev_b32 v21, 1, v20
    v_lshl_add_u32 v21, v21, 10, s50
    v_and_b32 v20, 1, v20
    v_lshl_add_u32 v21, v20, 7, v21
    v_cmp_gt_u32 vcc, 18, v1
    s_nop 1
    v_cndmask_b32 v5, v21, v5, vcc
    v_mul_lo_u32 v5, v5, s6
    s_waitcnt lgkmcnt(0)
    s_lshl_b32 s50, s4, 4
    s_load_dwordx4 s[60:63], s[30:31], s50
    s_add_u32 s48, s48, 0x01010101
    s_and_b32 s44, s48, 0xff
    s_bfe_u32 s45, s48, 0x80008
    s_bfe_u32 s46, s48, 0x80010
    s_lshr_b32 s47, s48, 24
    s_waitcnt lgkmcnt(0)
    s_mul_i32 s40, s40, 0x01010101
    s_mov_b32 s41, s40
    s_xor_b64 s[60:61], s[60:61], s[40:41]
    s_xor_b64 s[62:63], s[62:63], s[40:41]
    s_or_b64 s[60:61], s[60:61], s[62:63]
    s_or_b32 s60, s60, s61
    s_barrier
    s_cmp_lg_u32 s6, 0
    s_cbranch_scc1 L_nos1
    ds_read_b64_tr_b16 v[80:81], v6 offset:9728
    ds_read_b64_tr_b16 v[82:83], v6 offset:14336
    ds_read_b64_tr_b16 v[84:85], v6 offset:18944
    ds_read_b64_tr_b16 v[86:87], v6 offset:23552
    ds_read_b64_tr_b16 v[88:89], v6 offset:28160
    ds_read_b64_tr_b16 v[90:91], v6 offset:32768
    ds_read_b64_tr_b16 v[92:93], v6 offset:37376
    ds_read_b64_tr_b16 v[94:95], v6 offset:41984
    ds_read_b64_tr_b16 v[96:97], v6 offset:46592
    ds_read_b128 v[100:103], v7 offset:0
    ds_read_b128 v[104:107], v7 offset:64
    ds_read_b128 v[108:111], v7 offset:128
    ds_read_b128 v[112:115], v7 offset:192
    ds_read_b64 v[116:117], v7 offset:256
    s_waitcnt lgkmcnt(4)
    v_mfma_f32_16x16x32_bf16 v[120:123], v[80:83], v[100:103], 0
    s_waitcnt lgkmcnt(3)
    v_mfma_f32_16x16x32_bf16 v[120:123], v[84:87], v[104:107], v[120:123]
    s_waitcnt lgkmcnt(2)
    v_mfma_f32_16x16x32_bf16 v[120:123], v[88:91], v[108:111], v[120:123]
    s_waitcnt lgkmcnt(1)
    v_mfma_f32_16x16x32_bf16 v[120:123], v[92:95], v[112:115], v[120:123]
    s_waitcnt lgkmcnt(0)
    v_mfma_f32_16x16x32_bf16 v[120:123], v[96:99], v[116:119], v[120:123]
    s_mov_b32 exec_lo, 0x000f000f
    s_mov_b32 exec_hi, 0x000f000f
    s_cmp_lg_u32 s60, 0
    s_nop 4
    v_bfi_b32 v120, v11, s44, v120
    v_bfi_b32 v121, v11, s45, v121
    v_bfi_b32 v122, v11, s46, v122
    v_bfi_b32 v123, v11, s47, v123
    s_cbranch_scc0 L_near5
    global_store_dwordx4 v8, v[120:123], s[26:27] sc1
    s_branch L_sent6
L_near5:
    global_store_dwordx4 v8, v[120:123], s[26:27]
L_sent6:
    s_mov_b64 exec, -1
L_nos1:
    s_barrier
    global_load_dword v5, v5, s[26:27] sc1
    s_waitcnt vmcnt(0)
L_qpoll:
    global_load_dwordx4 v[60:63], v16, s[26:27] sc1
    global_load_dwordx4 v[64:67], v17, s[26:27] sc1
    global_load_dwordx4 v[68:71], v18, s[26:27] sc1
    global_load_dwordx4 v[72:75], v19, s[26:27] sc1
    s_waitcnt vmcnt(0)
    v_xor_b32 v60, s44, v60
    v_xor_b32 v61, s45, v61
    v_xor_b32 v62, s46, v62
    v_xor_b32 v63, s47, v63
    v_xor_b32 v64, s44, v64
    v_xor_b32 v65, s45, v65
    v_xor_b32 v66, s46, v66
    v_xor_b32 v67, s47, v67
    v_xor_b32 v68, s44, v68
    v_xor_b32 v69, s45, v69
    v_xor_b32 v70, s46, v70
    v_xor_b32 v71, s47, v71
    v_xor_b32 v72, s44, v72
    v_xor_b32 v73, s45, v73
    v_xor_b32 v74, s46, v74
    v_xor_b32 v75, s47, v75
    v_or3_b32 v76, v60, v61, v62
    v_or3_b32 v76, v76, v63, v64
    v_or3_b32 v76, v76, v65, v66
    v_or3_b32 v76, v76, v67, v68
    v_or3_b32 v76, v76, v69, v70
    v_or3_b32 v76, v76, v71, v72
    v_or3_b32 v76, v76, v73, v74
    v_or_b32 v76, v76, v75
    v_and_b32 v76, v11, v76
    v_cmp_ne_u32 vcc, 0, v76
    s_cbranch_vccz L_qgot
    s_sub_u32 s49, s49, 1
    s_cbranch_scc0 L_qpoll
    s_mov_b32 s49, 0
L_qgot:
    v_permlane32_swap_b32 v60, v62
    v_permlane32_swap_b32 v61, v63
    v_permlane32_swap_b32 v64, v66
    v_permlane32_swap_b32 v65, v67
    v_permlane32_swap_b32 v68, v70
    v_permlane32_swap_b32 v69, v71
    v_permlane32_swap_b32 v72, v74
    v_permlane32_swap_b32 v73, v75
    v_pk_add_f32 v[60:61], v[60:61], v[62:63]
    v_pk_add_f32 v[64:65], v[64:65], v[66:67]
    v_pk_add_f32 v[68:69], v[68:69], v[70:71]
    v_pk_add_f32 v[72:73], v[72:73], v[74:75]
    v_permlane16_swap_b32 v60, v61
    v_permlane16_swap_b32 v64, v65
    v_permlane16_swap_b32 v68, v69
    v_permlane16_swap_b32 v72, v73
    v_add_f32 v60, v60, v61
    v_add_f32 v64, v64, v65
    v_add_f32 v68, v68, v69
    v_add_f32 v72, v72, v73
    v_cvt_pk_bf16_f32 v60, v60, v60
    v_cvt_pk_bf16_f32 v64, v64, v64
    v_cvt_pk_bf16_f32 v68, v68, v68
    v_cvt_pk_bf16_f32 v72, v72, v72
    ds_write_b16 v9, v60 offset:3200
    ds_write_b16 v9, v64 offset:3328
    ds_write_b16 v9, v68 offset:3472
    ds_write_b16 v9, v72 offset:3600
    s_mul_i32 s50, s7, 9
    s_add_u32 s50, s50, s3
    s_lshl_b32 s50, s50, 10
    s_add_u32 s50, s50, 4096
    v_lshl_add_u32 v128, v1, 4, s50
    s_lshr_b32 s50, s3, 1
    s_lshl_b32 s50, s50, 6
    s_and_b32 s54, s3, 1
    s_lshl3_add_u32 s50, s54, s50
    v_bfe_u32 v129, v1, 2, 2
    v_mul_u32_u24 v129, 400, v129
    v_lshl_add_u32 v129, v12, 4, v129
    v_lshl_add_u32 v129, v14, 1, v129
    v_add_u32 v129, s50, v129
    s_cmp_lg_u32 s6, 0
    s_cbranch_scc1 L_noh
    global_load_dwordx4 v[100:103], v128, s[26:27] sc1
L_noh:
    s_waitcnt lgkmcnt(0)
    s_barrier
    s_mov_b32 s52, 0xbfb8aa3b
    v_and_b32 v17, 1, v1
    s_mul_i32 s50, s28, 1120
    s_sub_u32 s53, s53, s50
    v_lshl_add_u32 v19, v17, 4, s53
    v_lshlrev_b32 v16, 5, v14
    v_lshl_add_u32 v16, v17, 4, v16
    v_lshlrev_b32 v17, 2, v17
    v_mov_b32 v56, 0x3f803f80
    v_mov_b32 v57, 0x3f803f80
    v_mov_b32 v58, 0x3f803f80
    v_mov_b32 v59, 0x3f803f80
    v_add_u32 v6, 51200, v6
    s_lshl4_add_u32 s50, s4, s5
    v_mov_b32 v8, s50
    s_andn2_b32 s50, s50, 15
    v_or_b32 v9, s50, v13
    v_mov_b32 v10, 0x40
    s_mul_i32 s50, s56, 16640
    s_lshl_b32 s53, s57, 6
    s_add_u32 s50, s50, s53
    s_add_u32 s50, s50, 888832
    v_lshrrev_b32 v124, 2, v1
    v_lshl_add_u32 v124, v124, 8, s50
    v_lshl_add_u32 v124, v12, 4, v124
    v_add_u32 v125, 4096, v124
    v_add_u32 v126, 8192, v124
    v_add_u32 v127, 12288, v124
    v_lshlrev_b32 v4, 16, v4
    s_and_b32 s40, s40, 0xff
    s_movk_i32 s41, 4096
    s_barrier
    s_barrier
    ds_read_b32 v60, v17 offset:3776
    ds_read_b128 v[64:67], v16 offset:3904
    ds_read_b128 v[68:71], v16 offset:4032
    ds_read_b128 v[72:75], v16 offset:4160
    ds_read_b128 v[76:79], v16 offset:4288
    ds_read_b128 v[80:83], v16 offset:4416
    ds_read_b128 v[84:87], v16 offset:4544
    ds_read_b128 v[88:91], v16 offset:4672
    ds_read_b128 v[92:95], v16 offset:4800
    s_waitcnt lgkmcnt(7)
    v_mfma_f32_16x16x32_bf16 v[120:123], v[56:59], v[64:67], 0
    s_waitcnt lgkmcnt(6)
    v_mfma_f32_16x16x32_bf16 v[120:123], v[56:59], v[68:71], v[120:123]
    s_waitcnt lgkmcnt(5)
    v_mfma_f32_16x16x32_bf16 v[120:123], v[56:59], v[72:75], v[120:123]
    s_waitcnt lgkmcnt(4)
    v_mfma_f32_16x16x32_bf16 v[120:123], v[56:59], v[76:79], v[120:123]
    s_waitcnt lgkmcnt(3)
    v_mfma_f32_16x16x32_bf16 v[120:123], v[56:59], v[80:83], v[120:123]
    s_waitcnt lgkmcnt(2)
    v_mfma_f32_16x16x32_bf16 v[120:123], v[56:59], v[84:87], v[120:123]
    s_waitcnt lgkmcnt(1)
    v_mfma_f32_16x16x32_bf16 v[120:123], v[56:59], v[88:91], v[120:123]
    s_waitcnt lgkmcnt(0)
    v_mfma_f32_16x16x32_bf16 v[120:123], v[56:59], v[92:95], v[120:123]
    v_bfi_b32 v62, v11, s46, v60
    v_bfi_b32 v60, v11, s44, v60
    s_nop 5
    v_bfi_b32 v61, v11, s45, v120
    v_bfi_b32 v63, v11, s47, v120
    s_mov_b64 exec, 3
    s_cmp_lg_u32 s60, 0
    s_cbranch_scc0 L_near7
    global_store_dwordx4 v19, v[60:63], s[26:27] offset:1024 sc1
    s_branch L_sent8
L_near7:
    global_store_dwordx4 v19, v[60:63], s[26:27] offset:1024
L_sent8:
    s_mov_b64 exec, -1
    s_barrier
    s_barrier
    s_barrier
    s_waitcnt vmcnt(1)
    s_cmp_eq_u32 s6, 0
    s_cbranch_scc1 L_hchk
    s_branch L_b3c
L_final:
    s_mov_b64 exec, 1
    global_store_byte v8, v10, s[30:31]
    s_mov_b64 exec, -1
    s_cmp_ge_u32 s56, 36
    s_cbranch_scc1 L_fin
L_gp:
    global_load_ubyte v20, v9, s[30:31] sc1
    s_waitcnt vmcnt(0)
    v_cmp_eq_u32 vcc, s40, v20
    s_cbranch_vccz L_fpoll
    s_sub_u32 s41, s41, 1
    s_cbranch_scc0 L_gp
L_fpoll:
    global_load_dwordx4 v[40:43], v126, s[26:27] sc1
    global_load_dwordx4 v[44:47], v127, s[26:27] sc1
    global_load_dwordx4 v[32:35], v124, s[26:27] sc1
    global_load_dwordx4 v[36:39], v125, s[26:27] sc1
    s_waitcnt vmcnt(2)
    v_xor_b32 v40, s44, v40
    v_xor_b32 v41, s45, v41
    v_xor_b32 v42, s46, v42
    v_xor_b32 v43, s47, v43
    v_xor_b32 v44, s44, v44
    v_xor_b32 v45, s45, v45
    v_xor_b32 v46, s46, v46
    v_xor_b32 v47, s47, v47
    v_or3_b32 v19, v40, v41, v42
    v_or3_b32 v19, v19, v43, v44
    v_or3_b32 v19, v19, v45, v46
    v_or_b32 v19, v19, v47
    v_and_b32 v19, v11, v19
    v_cmp_ne_u32 vcc, 0, v19
    v_pk_add_f32 v[28:29], v[40:41], v[44:45]
    v_pk_add_f32 v[30:31], v[42:43], v[46:47]
    s_cbranch_vccz L_sgot
    s_sub_u32 s49, s49, 1
    s_cbranch_scc0 L_fpoll
    s_mov_b32 s49, 0
L_sgot:
    s_waitcnt vmcnt(0)
    v_xor_b32 v32, s44, v32
    v_xor_b32 v33, s45, v33
    v_xor_b32 v34, s46, v34
    v_xor_b32 v35, s47, v35
    v_xor_b32 v36, s44, v36
    v_xor_b32 v37, s45, v37
    v_xor_b32 v38, s46, v38
    v_xor_b32 v39, s47, v39
    v_or3_b32 v19, v32, v33, v34
    v_or3_b32 v19, v19, v35, v36
    v_or3_b32 v19, v19, v37, v38
    v_or_b32 v19, v19, v39
    v_and_b32 v19, v11, v19
    v_cmp_ne_u32 vcc, 0, v19
    v_pk_add_f32 v[20:21], v[32:33], v[36:37]
    v_pk_add_f32 v[22:23], v[34:35], v[38:39]
    s_cbranch_vccz L_fgot
    global_load_dwordx4 v[32:35], v124, s[26:27] sc1
    global_load_dwordx4 v[36:39], v125, s[26:27] sc1
    v_permlane32_swap_b32 v28, v30
    v_permlane32_swap_b32 v29, v31
    v_pk_add_f32 v[28:29], v[28:29], v[30:31]
    s_nop 1
    v_permlane16_swap_b32 v28, v29
    v_add_f32 v28, v28, v29
    s_nop 1
    v_add_f32_dpp v28, v28, v28 row_ror:4 row_mask:0xf bank_mask:0xf
    s_nop 1
    v_add_f32_dpp v28, v28, v28 row_ror:8 row_mask:0xf bank_mask:0xf
    s_branch L_fchk
L_fp2:
    global_load_dwordx4 v[32:35], v124, s[26:27] sc1
    global_load_dwordx4 v[36:39], v125, s[26:27] sc1
L_fchk:
    s_waitcnt vmcnt(0)
    v_xor_b32 v32, s44, v32
    v_xor_b32 v33, s45, v33
    v_xor_b32 v34, s46, v34
    v_xor_b32 v35, s47, v35
    v_xor_b32 v36, s44, v36
    v_xor_b32 v37, s45, v37
    v_xor_b32 v38, s46, v38
    v_xor_b32 v39, s47, v39
    v_or3_b32 v19, v32, v33, v34
    v_or3_b32 v19, v19, v35, v36
    v_or3_b32 v19, v19, v37, v38
    v_or_b32 v19, v19, v39
    v_and_b32 v19, v11, v19
    v_cmp_ne_u32 vcc, 0, v19
    v_pk_add_f32 v[20:21], v[32:33], v[36:37]
    v_pk_add_f32 v[22:23], v[34:35], v[38:39]
    s_cbranch_vccz L_fg2
    s_sub_u32 s49, s49, 1
    s_cbranch_scc0 L_fp2
    s_mov_b32 s49, 0
L_fg2:
    s_nop 0
    v_permlane32_swap_b32 v20, v22
    v_permlane32_swap_b32 v21, v23
    v_pk_add_f32 v[20:21], v[20:21], v[22:23]
    s_nop 1
    v_permlane16_swap_b32 v20, v21
    v_add_f32 v20, v20, v21
    s_nop 1
    v_add_f32_dpp v20, v20, v20 row_ror:4 row_mask:0xf bank_mask:0xf
    s_nop 1
    v_add_f32_dpp v20, v20, v20 row_ror:8 row_mask:0xf bank_mask:0xf
    s_branch L_fmath
L_fgot:
    s_nop 0
    v_permlane32_swap_b32 v20, v22
    v_permlane32_swap_b32 v21, v23
    v_permlane32_swap_b32 v28, v30
    v_permlane32_swap_b32 v29, v31
    v_pk_add_f32 v[20:21], v[20:21], v[22:23]
    v_pk_add_f32 v[28:29], v[28:29], v[30:31]
    s_nop 0
    v_permlane16_swap_b32 v20, v21
    v_permlane16_swap_b32 v28, v29
    v_add_f32 v20, v20, v21
    v_add_f32 v28, v28, v29
    s_nop 0
    v_add_f32_dpp v20, v20, v20 row_ror:4 row_mask:0xf bank_mask:0xf
    v_add_f32_dpp v28, v28, v28 row_ror:4 row_mask:0xf bank_mask:0xf
    s_nop 0
    v_add_f32_dpp v20, v20, v20 row_ror:8 row_mask:0xf bank_mask:0xf
    v_add_f32_dpp v28, v28, v28 row_ror:8 row_mask:0xf bank_mask:0xf
L_fmath:
    v_cvt_pk_bf16_f32 v20, v28, v20
    v_and_b32 v21, s51, v20
    v_lshlrev_b32 v20, 16, v20
    v_mul_f32 v22, s52, v21
    v_exp_f32 v22, v22
    s_nop 0
    v_add_f32 v22, 1.0, v22
    v_rcp_f32 v22, v22
    s_nop 0
    v_mul_f32 v21, v21, v22
    v_cvt_pk_bf16_f32 v21, v21, v21
    v_and_b32 v21, s51, v21
    v_mul_f32 v20, v20, v21
    v_cvt_pk_bf16_f32 v20, v20, v20
    v_and_b32 v20, s51, v20
    v_add_f32 v20, v4, v20
    v_cvt_pk_bf16_f32 v20, v20, v20
    s_mov_b32 exec_lo, 0x000f000f
    s_mov_b32 exec_hi, 0x000f000f
    global_store_short v3, v20, s[24:25]
    s_cmp_lg_u32 s2, 224
    s_cbranch_scc1 L_fin
    s_mov_b64 exec, 1
    v_mov_b32 v22, s48
    global_store_dword v98, v22, s[26:27] offset:0
L_fin:
L_end:
    s_endpgm
.section .rodata,"a"
.p2align 6
.amdhsa_kernel recurrent_scan__sliding_block_cached__dense_activation_silu__decode_kernel
  .amdhsa_next_free_vgpr 136
  .amdhsa_next_free_sgpr 64
  .amdhsa_accum_offset 136
  .amdhsa_group_segment_fixed_size 0
  .amdhsa_kernarg_size 88
  .amdhsa_user_sgpr_count 2
  .amdhsa_user_sgpr_kernarg_segment_ptr 1
  .amdhsa_system_sgpr_workgroup_id_x 1
  .amdhsa_float_denorm_mode_32 3
.end_amdhsa_kernel
```
